```python
import torch

def _softmax(x, axis=-1):
    return torch.softmax(x, dim=axis)
def _gelu(x):
    return torch.nn.functional.gelu(x, approximate="tanh")
def _silu(x):
    return torch.nn.functional.silu(x)
def _sigmoid(x):
    return torch.sigmoid(x)
def _layernorm(x, axis=-1, eps=1e-5):
    m = x.mean(dim=axis, keepdim=True)
    v = x.var(dim=axis, keepdim=True, unbiased=False)
    return (x - m) / torch.sqrt(v + eps)
def _scatter_add(tgt, idx, src, axis=0):
    return tgt.clone().index_add_(axis, idx, src)
def _segment_sum(src, seg, n):
    out = torch.zeros((n,) + src.shape[1:], dtype=src.dtype)
    return out.index_add_(0, seg, src)
def _pad(x, pw):
    flat = tuple(v for pair in reversed(pw) for v in pair)
    return torch.nn.functional.pad(x, flat)

kernel_name = 'standalone__groupnorm__sampling'

def setup_inputs():

    _w = (lambda a: (lambda t: t.to(torch.bfloat16) if t.is_floating_point() else t)(torch.as_tensor(a)))
    B = 32
    G = 32
    cpg = max(1, 1024 // G)
    C = G * cpg
    H, W = 32, 16
    return {
        "x": _w(abs((lambda *s: torch.randn(*s, dtype=torch.bfloat16) * 0.05)(B, C, H, W))),
        "g": _w((lambda *s: torch.randn(*s, dtype=torch.bfloat16) * 0.05)(C) + 1.0),
        "b": _w((lambda *s: torch.randn(*s, dtype=torch.bfloat16) * 0.4)(C)),
    }

def reference(x, g, b):
    G = 32
    B, C, H, W = x.shape[0], x.shape[1], x.shape[2], x.shape[3]
    xr = x.reshape(B, G, C // G, H, W)
    mu = xr.mean(axis=(2, 3, 4), keepdims=True)
    var = ((xr - mu) ** 2).mean(axis=(2, 3, 4), keepdims=True)
    xn = (xr - mu) / torch.sqrt(var + 1e-5)
    xn = xn.reshape(B, C, H, W)
    return xn * g[None, :, None, None] + b[None, :, None, None]
```

```asm
; @launch grid=(512,1,1) block=(512,1,1) lds=64
.amdgcn_target "amdgcn-amd-amdhsa--gfx950"
.text
.globl standalone__groupnorm__sampling_kernel
.p2align 8
.type standalone__groupnorm__sampling_kernel,@function
standalone__groupnorm__sampling_kernel:
    s_load_dwordx8 s[4:11], s[0:1], 0
    s_setprio 3
    s_cmp_ge_u32 s2, 512
    s_cbranch_scc1 L_end
    v_readfirstlane_b32 s3, v0
    v_and_b32 v2, 255, v0
    v_lshlrev_b32 v1, 4, v2
    s_lshr_b32 s29, s3, 8
    s_and_b32 s30, s3, 0xc0
    s_lshl_b32 s28, s29, 9
    s_add_u32 s28, s28, s2
    s_lshl_b32 s12, s28, 15
    s_add_u32 s13, s12, 4096
    v_add_u32 v1, s13, v1
    v_add_u32 v80, 0x2000, v1
    v_add_u32 v81, 0x4000, v1
    v_add_u32 v82, 0x6000, v1
    s_and_b32 s14, s28, 31
    s_lshl_b32 s14, s14, 6
    s_waitcnt lgkmcnt(0)
    global_load_dwordx4 v[8:11], v1, s[4:5] offset:-4096 nt
    global_load_dwordx4 v[16:19], v80, s[4:5] offset:-4096 nt
    global_load_dwordx4 v[24:27], v81, s[4:5] offset:-4096 nt
    global_load_dwordx4 v[32:35], v82, s[4:5] offset:-4096 nt
    global_load_dwordx4 v[12:15], v1, s[4:5] offset:0 nt
    global_load_dwordx4 v[20:23], v80, s[4:5] offset:0 nt
    global_load_dwordx4 v[28:31], v81, s[4:5] offset:0 nt
    global_load_dwordx4 v[36:39], v82, s[4:5] offset:0 nt
    s_load_dword s24, s[4:5], s12
    s_load_dwordx16 s[32:47], s[6:7], s14
    s_load_dwordx16 s[48:63], s[8:9], s14
    v_mov_b32 v2, 0x00003f80
    v_mov_b32 v3, 0x3f800000
    v_mov_b32 v4, 0
    v_mov_b32 v5, 0
    v_mov_b32 v6, 0
    v_mov_b32 v7, 0
    s_lshl_b32 s31, s29, 5
    s_lshr_b32 s15, s30, 3
    s_add_u32 s15, s15, s31
    s_mov_b32 s26, 0x38800000
    s_mov_b32 s27, 0x3727c5ac
    s_and_b32 s16, s30, 64
    s_cselect_b32 s16, 0, 16
    s_waitcnt lgkmcnt(0)
    s_lshl_b32 s24, s24, 16
    s_xor_b32 s24, s24, 0x80000000
    s_bitcmp1_b32 s30, 7
    s_cselect_b32 s32, s33, s32
    s_cselect_b32 s48, s49, s48
    s_cselect_b32 s34, s35, s34
    s_cselect_b32 s50, s51, s50
    s_cselect_b32 s36, s37, s36
    s_cselect_b32 s52, s53, s52
    s_cselect_b32 s38, s39, s38
    s_cselect_b32 s54, s55, s54
    s_cselect_b32 s40, s41, s40
    s_cselect_b32 s56, s57, s56
    s_cselect_b32 s42, s43, s42
    s_cselect_b32 s58, s59, s58
    s_cselect_b32 s44, s45, s44
    s_cselect_b32 s60, s61, s60
    s_cselect_b32 s46, s47, s46
    s_cselect_b32 s62, s63, s62
    s_lshl_b32 s32, s32, s16
    s_and_b32 s32, s32, 0xffff0000
    s_lshl_b32 s48, s48, s16
    s_and_b32 s48, s48, 0xffff0000
    s_lshl_b32 s34, s34, s16
    s_and_b32 s34, s34, 0xffff0000
    s_lshl_b32 s50, s50, s16
    s_and_b32 s50, s50, 0xffff0000
    s_lshl_b32 s36, s36, s16
    s_and_b32 s36, s36, 0xffff0000
    s_lshl_b32 s52, s52, s16
    s_and_b32 s52, s52, 0xffff0000
    s_lshl_b32 s38, s38, s16
    s_and_b32 s38, s38, 0xffff0000
    s_lshl_b32 s54, s54, s16
    s_and_b32 s54, s54, 0xffff0000
    s_lshl_b32 s40, s40, s16
    s_and_b32 s40, s40, 0xffff0000
    s_lshl_b32 s56, s56, s16
    s_and_b32 s56, s56, 0xffff0000
    s_lshl_b32 s42, s42, s16
    s_and_b32 s42, s42, 0xffff0000
    s_lshl_b32 s58, s58, s16
    s_and_b32 s58, s58, 0xffff0000
    s_lshl_b32 s44, s44, s16
    s_and_b32 s44, s44, 0xffff0000
    s_lshl_b32 s60, s60, s16
    s_and_b32 s60, s60, 0xffff0000
    s_lshl_b32 s46, s46, s16
    s_and_b32 s46, s46, 0xffff0000
    s_lshl_b32 s62, s62, s16
    s_and_b32 s62, s62, 0xffff0000
    s_waitcnt vmcnt(7)
    v_dot2_f32_bf16 v40, v8, v2, s24
    v_dot2_f32_bf16 v41, v9, v2, s24
    v_dot2_f32_bf16 v42, v10, v2, s24
    v_dot2_f32_bf16 v43, v11, v2, s24
    v_dot2_f32_bf16 v8, v8, v3, s24
    v_dot2_f32_bf16 v9, v9, v3, s24
    v_dot2_f32_bf16 v10, v10, v3, s24
    v_dot2_f32_bf16 v11, v11, v3, s24
    v_pk_add_f32 v[4:5], v[4:5], v[40:41]
    v_pk_fma_f32 v[6:7], v[40:41], v[40:41], v[6:7]
    v_pk_add_f32 v[4:5], v[4:5], v[42:43]
    v_pk_fma_f32 v[6:7], v[42:43], v[42:43], v[6:7]
    v_pk_add_f32 v[4:5], v[4:5], v[8:9]
    v_pk_fma_f32 v[6:7], v[8:9], v[8:9], v[6:7]
    v_pk_add_f32 v[4:5], v[4:5], v[10:11]
    v_pk_fma_f32 v[6:7], v[10:11], v[10:11], v[6:7]
    s_waitcnt vmcnt(6)
    v_dot2_f32_bf16 v48, v16, v2, s24
    v_dot2_f32_bf16 v49, v17, v2, s24
    v_dot2_f32_bf16 v50, v18, v2, s24
    v_dot2_f32_bf16 v51, v19, v2, s24
    v_dot2_f32_bf16 v16, v16, v3, s24
    v_dot2_f32_bf16 v17, v17, v3, s24
    v_dot2_f32_bf16 v18, v18, v3, s24
    v_dot2_f32_bf16 v19, v19, v3, s24
    v_pk_add_f32 v[4:5], v[4:5], v[48:49]
    v_pk_fma_f32 v[6:7], v[48:49], v[48:49], v[6:7]
    v_pk_add_f32 v[4:5], v[4:5], v[50:51]
    v_pk_fma_f32 v[6:7], v[50:51], v[50:51], v[6:7]
    v_pk_add_f32 v[4:5], v[4:5], v[16:17]
    v_pk_fma_f32 v[6:7], v[16:17], v[16:17], v[6:7]
    v_pk_add_f32 v[4:5], v[4:5], v[18:19]
    v_pk_fma_f32 v[6:7], v[18:19], v[18:19], v[6:7]
    s_waitcnt vmcnt(5)
    v_dot2_f32_bf16 v56, v24, v2, s24
    v_dot2_f32_bf16 v57, v25, v2, s24
    v_dot2_f32_bf16 v58, v26, v2, s24
    v_dot2_f32_bf16 v59, v27, v2, s24
    v_dot2_f32_bf16 v24, v24, v3, s24
    v_dot2_f32_bf16 v25, v25, v3, s24
    v_dot2_f32_bf16 v26, v26, v3, s24
    v_dot2_f32_bf16 v27, v27, v3, s24
    v_pk_add_f32 v[4:5], v[4:5], v[56:57]
    v_pk_fma_f32 v[6:7], v[56:57], v[56:57], v[6:7]
    v_pk_add_f32 v[4:5], v[4:5], v[58:59]
    v_pk_fma_f32 v[6:7], v[58:59], v[58:59], v[6:7]
    v_pk_add_f32 v[4:5], v[4:5], v[24:25]
    v_pk_fma_f32 v[6:7], v[24:25], v[24:25], v[6:7]
    v_pk_add_f32 v[4:5], v[4:5], v[26:27]
    v_pk_fma_f32 v[6:7], v[26:27], v[26:27], v[6:7]
    s_waitcnt vmcnt(4)
    v_dot2_f32_bf16 v64, v32, v2, s24
    v_dot2_f32_bf16 v65, v33, v2, s24
    v_dot2_f32_bf16 v66, v34, v2, s24
    v_dot2_f32_bf16 v67, v35, v2, s24
    v_dot2_f32_bf16 v32, v32, v3, s24
    v_dot2_f32_bf16 v33, v33, v3, s24
    v_dot2_f32_bf16 v34, v34, v3, s24
    v_dot2_f32_bf16 v35, v35, v3, s24
    v_pk_add_f32 v[4:5], v[4:5], v[64:65]
    v_pk_fma_f32 v[6:7], v[64:65], v[64:65], v[6:7]
    v_pk_add_f32 v[4:5], v[4:5], v[66:67]
    v_pk_fma_f32 v[6:7], v[66:67], v[66:67], v[6:7]
    v_pk_add_f32 v[4:5], v[4:5], v[32:33]
    v_pk_fma_f32 v[6:7], v[32:33], v[32:33], v[6:7]
    v_pk_add_f32 v[4:5], v[4:5], v[34:35]
    v_pk_fma_f32 v[6:7], v[34:35], v[34:35], v[6:7]
    s_waitcnt vmcnt(3)
    v_dot2_f32_bf16 v44, v12, v2, s24
    v_dot2_f32_bf16 v45, v13, v2, s24
    v_dot2_f32_bf16 v46, v14, v2, s24
    v_dot2_f32_bf16 v47, v15, v2, s24
    v_dot2_f32_bf16 v12, v12, v3, s24
    v_dot2_f32_bf16 v13, v13, v3, s24
    v_dot2_f32_bf16 v14, v14, v3, s24
    v_dot2_f32_bf16 v15, v15, v3, s24
    v_pk_add_f32 v[4:5], v[4:5], v[44:45]
    v_pk_fma_f32 v[6:7], v[44:45], v[44:45], v[6:7]
    v_pk_add_f32 v[4:5], v[4:5], v[46:47]
    v_pk_fma_f32 v[6:7], v[46:47], v[46:47], v[6:7]
    v_pk_add_f32 v[4:5], v[4:5], v[12:13]
    v_pk_fma_f32 v[6:7], v[12:13], v[12:13], v[6:7]
    v_pk_add_f32 v[4:5], v[4:5], v[14:15]
    v_pk_fma_f32 v[6:7], v[14:15], v[14:15], v[6:7]
    s_waitcnt vmcnt(2)
    v_dot2_f32_bf16 v52, v20, v2, s24
    v_dot2_f32_bf16 v53, v21, v2, s24
    v_dot2_f32_bf16 v54, v22, v2, s24
    v_dot2_f32_bf16 v55, v23, v2, s24
    v_dot2_f32_bf16 v20, v20, v3, s24
    v_dot2_f32_bf16 v21, v21, v3, s24
    v_dot2_f32_bf16 v22, v22, v3, s24
    v_dot2_f32_bf16 v23, v23, v3, s24
    v_pk_add_f32 v[4:5], v[4:5], v[52:53]
    v_pk_fma_f32 v[6:7], v[52:53], v[52:53], v[6:7]
    v_pk_add_f32 v[4:5], v[4:5], v[54:55]
    v_pk_fma_f32 v[6:7], v[54:55], v[54:55], v[6:7]
    v_pk_add_f32 v[4:5], v[4:5], v[20:21]
    v_pk_fma_f32 v[6:7], v[20:21], v[20:21], v[6:7]
    v_pk_add_f32 v[4:5], v[4:5], v[22:23]
    v_pk_fma_f32 v[6:7], v[22:23], v[22:23], v[6:7]
    s_waitcnt vmcnt(1)
    v_dot2_f32_bf16 v60, v28, v2, s24
    v_dot2_f32_bf16 v61, v29, v2, s24
    v_dot2_f32_bf16 v62, v30, v2, s24
    v_dot2_f32_bf16 v63, v31, v2, s24
    v_dot2_f32_bf16 v28, v28, v3, s24
    v_dot2_f32_bf16 v29, v29, v3, s24
    v_dot2_f32_bf16 v30, v30, v3, s24
    v_dot2_f32_bf16 v31, v31, v3, s24
    v_pk_add_f32 v[4:5], v[4:5], v[60:61]
    v_pk_fma_f32 v[6:7], v[60:61], v[60:61], v[6:7]
    v_pk_add_f32 v[4:5], v[4:5], v[62:63]
    v_pk_fma_f32 v[6:7], v[62:63], v[62:63], v[6:7]
    v_pk_add_f32 v[4:5], v[4:5], v[28:29]
    v_pk_fma_f32 v[6:7], v[28:29], v[28:29], v[6:7]
    v_pk_add_f32 v[4:5], v[4:5], v[30:31]
    v_pk_fma_f32 v[6:7], v[30:31], v[30:31], v[6:7]
    s_waitcnt vmcnt(0)
    v_dot2_f32_bf16 v68, v36, v2, s24
    v_dot2_f32_bf16 v69, v37, v2, s24
    v_dot2_f32_bf16 v70, v38, v2, s24
    v_dot2_f32_bf16 v71, v39, v2, s24
    v_dot2_f32_bf16 v36, v36, v3, s24
    v_dot2_f32_bf16 v37, v37, v3, s24
    v_dot2_f32_bf16 v38, v38, v3, s24
    v_dot2_f32_bf16 v39, v39, v3, s24
    v_pk_add_f32 v[4:5], v[4:5], v[68:69]
    v_pk_fma_f32 v[6:7], v[68:69], v[68:69], v[6:7]
    v_pk_add_f32 v[4:5], v[4:5], v[70:71]
    v_pk_fma_f32 v[6:7], v[70:71], v[70:71], v[6:7]
    v_pk_add_f32 v[4:5], v[4:5], v[36:37]
    v_pk_fma_f32 v[6:7], v[36:37], v[36:37], v[6:7]
    v_pk_add_f32 v[4:5], v[4:5], v[38:39]
    v_pk_fma_f32 v[6:7], v[38:39], v[38:39], v[6:7]
    v_add_f32 v4, v4, v5
    v_add_f32 v5, v6, v7
    v_mov_b32 v6, s15
    v_mov_b32 v7, s31
    v_add_f32_dpp v4, v4, v4 quad_perm:[1,0,3,2] row_mask:0xf bank_mask:0xf
    v_add_f32_dpp v5, v5, v5 quad_perm:[1,0,3,2] row_mask:0xf bank_mask:0xf
    s_nop 0
    v_add_f32_dpp v4, v4, v4 quad_perm:[2,3,0,1] row_mask:0xf bank_mask:0xf
    v_add_f32_dpp v5, v5, v5 quad_perm:[2,3,0,1] row_mask:0xf bank_mask:0xf
    s_nop 0
    v_add_f32_dpp v4, v4, v4 row_half_mirror row_mask:0xf bank_mask:0xf
    v_add_f32_dpp v5, v5, v5 row_half_mirror row_mask:0xf bank_mask:0xf
    s_nop 0
    v_add_f32_dpp v4, v4, v4 row_mirror row_mask:0xf bank_mask:0xf
    v_add_f32_dpp v5, v5, v5 row_mirror row_mask:0xf bank_mask:0xf
    s_nop 0
    v_add_f32_dpp v4, v4, v4 row_bcast:15 row_mask:0xa bank_mask:0xf
    v_add_f32_dpp v5, v5, v5 row_bcast:15 row_mask:0xa bank_mask:0xf
    s_nop 0
    v_add_f32_dpp v4, v4, v4 row_bcast:31 row_mask:0xc bank_mask:0xf
    v_add_f32_dpp v5, v5, v5 row_bcast:31 row_mask:0xc bank_mask:0xf
    s_nop 0
    s_brev_b64 exec, 1
    ds_write_b64 v6, v[4:5]
    s_mov_b64 exec, -1
    s_waitcnt lgkmcnt(0)
    s_setprio 0
    s_barrier
    ds_read_b128 v[72:75], v7
    ds_read_b128 v[76:79], v7 offset:16
    s_waitcnt lgkmcnt(0)
    v_pk_add_f32 v[72:73], v[72:73], v[74:75]
    v_pk_add_f32 v[76:77], v[76:77], v[78:79]
    v_pk_add_f32 v[72:73], v[72:73], v[76:77]
    v_mul_f32 v4, s26, v72
    v_mul_f32 v5, s26, v73
    v_subrev_f32 v6, s24, v4
    v_fma_f32 v5, -v4, v4, v5
    v_cvt_pk_bf16_f32 v6, 0, v6
    v_add_f32 v7, s24, v6
    v_sub_f32 v4, v4, v7
    v_fma_f32 v5, v4, v4, v5
    v_cvt_pk_bf16_f32 v5, 0, v5
    v_add_f32 v5, s27, v5
    v_cvt_pk_bf16_f32 v5, 0, v5
    v_sqrt_f32 v5, v5
    v_mov_b32 v4, v7
    v_cvt_pk_bf16_f32 v5, 0, v5
    v_rcp_f32 v5, v5
    s_nop 0
    v_mul_f32 v6, s32, v5
    v_fma_f32 v7, -v4, v6, s48
    v_pk_fma_f32 v[40:41], v[40:41], v[6:7], v[6:7] op_sel:[0,0,1] op_sel_hi:[1,0,1]
    v_pk_fma_f32 v[8:9], v[8:9], v[6:7], v[6:7] op_sel:[0,0,1] op_sel_hi:[1,0,1]
    v_pk_fma_f32 v[42:43], v[42:43], v[6:7], v[6:7] op_sel:[0,0,1] op_sel_hi:[1,0,1]
    v_pk_fma_f32 v[10:11], v[10:11], v[6:7], v[6:7] op_sel:[0,0,1] op_sel_hi:[1,0,1]
    v_cvt_pk_bf16_f32 v8, v40, v8
    v_cvt_pk_bf16_f32 v9, v41, v9
    v_cvt_pk_bf16_f32 v10, v42, v10
    v_cvt_pk_bf16_f32 v11, v43, v11
    global_store_dwordx4 v1, v[8:11], s[10:11] offset:-4096 sc1
    v_mul_f32 v6, s36, v5
    v_fma_f32 v7, -v4, v6, s52
    v_pk_fma_f32 v[48:49], v[48:49], v[6:7], v[6:7] op_sel:[0,0,1] op_sel_hi:[1,0,1]
    v_pk_fma_f32 v[16:17], v[16:17], v[6:7], v[6:7] op_sel:[0,0,1] op_sel_hi:[1,0,1]
    v_pk_fma_f32 v[50:51], v[50:51], v[6:7], v[6:7] op_sel:[0,0,1] op_sel_hi:[1,0,1]
    v_pk_fma_f32 v[18:19], v[18:19], v[6:7], v[6:7] op_sel:[0,0,1] op_sel_hi:[1,0,1]
    v_cvt_pk_bf16_f32 v16, v48, v16
    v_cvt_pk_bf16_f32 v17, v49, v17
    v_cvt_pk_bf16_f32 v18, v50, v18
    v_cvt_pk_bf16_f32 v19, v51, v19
    global_store_dwordx4 v80, v[16:19], s[10:11] offset:-4096 sc1
    v_mul_f32 v6, s40, v5
    v_fma_f32 v7, -v4, v6, s56
    v_pk_fma_f32 v[56:57], v[56:57], v[6:7], v[6:7] op_sel:[0,0,1] op_sel_hi:[1,0,1]
    v_pk_fma_f32 v[24:25], v[24:25], v[6:7], v[6:7] op_sel:[0,0,1] op_sel_hi:[1,0,1]
    v_pk_fma_f32 v[58:59], v[58:59], v[6:7], v[6:7] op_sel:[0,0,1] op_sel_hi:[1,0,1]
    v_pk_fma_f32 v[26:27], v[26:27], v[6:7], v[6:7] op_sel:[0,0,1] op_sel_hi:[1,0,1]
    v_cvt_pk_bf16_f32 v24, v56, v24
    v_cvt_pk_bf16_f32 v25, v57, v25
    v_cvt_pk_bf16_f32 v26, v58, v26
    v_cvt_pk_bf16_f32 v27, v59, v27
    global_store_dwordx4 v81, v[24:27], s[10:11] offset:-4096 sc1
    v_mul_f32 v6, s44, v5
    v_fma_f32 v7, -v4, v6, s60
    v_pk_fma_f32 v[64:65], v[64:65], v[6:7], v[6:7] op_sel:[0,0,1] op_sel_hi:[1,0,1]
    v_pk_fma_f32 v[32:33], v[32:33], v[6:7], v[6:7] op_sel:[0,0,1] op_sel_hi:[1,0,1]
    v_pk_fma_f32 v[66:67], v[66:67], v[6:7], v[6:7] op_sel:[0,0,1] op_sel_hi:[1,0,1]
    v_pk_fma_f32 v[34:35], v[34:35], v[6:7], v[6:7] op_sel:[0,0,1] op_sel_hi:[1,0,1]
    v_cvt_pk_bf16_f32 v32, v64, v32
    v_cvt_pk_bf16_f32 v33, v65, v33
    v_cvt_pk_bf16_f32 v34, v66, v34
    v_cvt_pk_bf16_f32 v35, v67, v35
    global_store_dwordx4 v82, v[32:35], s[10:11] offset:-4096 sc1
    v_mul_f32 v6, s34, v5
    v_fma_f32 v7, -v4, v6, s50
    v_pk_fma_f32 v[44:45], v[44:45], v[6:7], v[6:7] op_sel:[0,0,1] op_sel_hi:[1,0,1]
    v_pk_fma_f32 v[12:13], v[12:13], v[6:7], v[6:7] op_sel:[0,0,1] op_sel_hi:[1,0,1]
    v_pk_fma_f32 v[46:47], v[46:47], v[6:7], v[6:7] op_sel:[0,0,1] op_sel_hi:[1,0,1]
    v_pk_fma_f32 v[14:15], v[14:15], v[6:7], v[6:7] op_sel:[0,0,1] op_sel_hi:[1,0,1]
    v_cvt_pk_bf16_f32 v12, v44, v12
    v_cvt_pk_bf16_f32 v13, v45, v13
    v_cvt_pk_bf16_f32 v14, v46, v14
    v_cvt_pk_bf16_f32 v15, v47, v15
    global_store_dwordx4 v1, v[12:15], s[10:11] offset:0 sc1
    v_mul_f32 v6, s38, v5
    v_fma_f32 v7, -v4, v6, s54
    v_pk_fma_f32 v[52:53], v[52:53], v[6:7], v[6:7] op_sel:[0,0,1] op_sel_hi:[1,0,1]
    v_pk_fma_f32 v[20:21], v[20:21], v[6:7], v[6:7] op_sel:[0,0,1] op_sel_hi:[1,0,1]
    v_pk_fma_f32 v[54:55], v[54:55], v[6:7], v[6:7] op_sel:[0,0,1] op_sel_hi:[1,0,1]
    v_pk_fma_f32 v[22:23], v[22:23], v[6:7], v[6:7] op_sel:[0,0,1] op_sel_hi:[1,0,1]
    v_cvt_pk_bf16_f32 v20, v52, v20
    v_cvt_pk_bf16_f32 v21, v53, v21
    v_cvt_pk_bf16_f32 v22, v54, v22
    v_cvt_pk_bf16_f32 v23, v55, v23
    global_store_dwordx4 v80, v[20:23], s[10:11] offset:0 sc1
    v_mul_f32 v6, s42, v5
    v_fma_f32 v7, -v4, v6, s58
    v_pk_fma_f32 v[60:61], v[60:61], v[6:7], v[6:7] op_sel:[0,0,1] op_sel_hi:[1,0,1]
    v_pk_fma_f32 v[28:29], v[28:29], v[6:7], v[6:7] op_sel:[0,0,1] op_sel_hi:[1,0,1]
    v_pk_fma_f32 v[62:63], v[62:63], v[6:7], v[6:7] op_sel:[0,0,1] op_sel_hi:[1,0,1]
    v_pk_fma_f32 v[30:31], v[30:31], v[6:7], v[6:7] op_sel:[0,0,1] op_sel_hi:[1,0,1]
    v_cvt_pk_bf16_f32 v28, v60, v28
    v_cvt_pk_bf16_f32 v29, v61, v29
    v_cvt_pk_bf16_f32 v30, v62, v30
    v_cvt_pk_bf16_f32 v31, v63, v31
    global_store_dwordx4 v81, v[28:31], s[10:11] offset:0 sc1
    v_mul_f32 v6, s46, v5
    v_fma_f32 v7, -v4, v6, s62
    v_pk_fma_f32 v[68:69], v[68:69], v[6:7], v[6:7] op_sel:[0,0,1] op_sel_hi:[1,0,1]
    v_pk_fma_f32 v[36:37], v[36:37], v[6:7], v[6:7] op_sel:[0,0,1] op_sel_hi:[1,0,1]
    v_pk_fma_f32 v[70:71], v[70:71], v[6:7], v[6:7] op_sel:[0,0,1] op_sel_hi:[1,0,1]
    v_pk_fma_f32 v[38:39], v[38:39], v[6:7], v[6:7] op_sel:[0,0,1] op_sel_hi:[1,0,1]
    v_cvt_pk_bf16_f32 v36, v68, v36
    v_cvt_pk_bf16_f32 v37, v69, v37
    v_cvt_pk_bf16_f32 v38, v70, v38
    v_cvt_pk_bf16_f32 v39, v71, v39
    global_store_dwordx4 v82, v[36:39], s[10:11] offset:0 sc1
L_end:
s_endpgm
.section .rodata,"a"
.p2align 6
.amdhsa_kernel standalone__groupnorm__sampling_kernel
  .amdhsa_next_free_vgpr 84
  .amdhsa_next_free_sgpr 64
  .amdhsa_accum_offset 84
  .amdhsa_group_segment_fixed_size 0
  .amdhsa_kernarg_size 48
  .amdhsa_user_sgpr_count 2
  .amdhsa_user_sgpr_kernarg_segment_ptr 1
  .amdhsa_system_sgpr_workgroup_id_x 1
  .amdhsa_float_denorm_mode_32 3
.end_amdhsa_kernel
```
